```python
import torch

def _softmax(x, axis=-1):
    return torch.softmax(x, dim=axis)
def _gelu(x):
    return torch.nn.functional.gelu(x, approximate="tanh")
def _silu(x):
    return torch.nn.functional.silu(x)
def _sigmoid(x):
    return torch.sigmoid(x)
def _layernorm(x, axis=-1, eps=1e-5):
    m = x.mean(dim=axis, keepdim=True)
    v = x.var(dim=axis, keepdim=True, unbiased=False)
    return (x - m) / torch.sqrt(v + eps)
def _scatter_add(tgt, idx, src, axis=0):
    return tgt.clone().index_add_(axis, idx, src)
def _segment_sum(src, seg, n):
    out = torch.zeros((n,) + src.shape[1:], dtype=src.dtype)
    return out.index_add_(0, seg, src)
def _pad(x, pw):
    flat = tuple(v for pair in reversed(pw) for v in pair)
    return torch.nn.functional.pad(x, flat)

kernel_name = 'standalone__grn__sampling'

def setup_inputs():

    _w = (lambda a: (lambda t: t.to(torch.bfloat16) if t.is_floating_point() else t)(torch.as_tensor(a)))
    B, S, D = 1024, 16, 640
    return {
        "x": _w((lambda *s: torch.randn(*s, dtype=torch.bfloat16) * 0.05)(B, S, D)),
        "g": _w((lambda *s: torch.randn(*s, dtype=torch.bfloat16) * 0.4)(D) * 0.1),
        "b": _w((lambda *s: torch.randn(*s, dtype=torch.bfloat16) * 0.1)(D) * 0.1),
    }

def reference(x, g, b):
    gx = torch.sqrt((x * x).sum(axis=-2, keepdims=True))
    nx = gx / (gx.mean(axis=-1, keepdims=True) + 1e-6)
    return g * (x * nx) + b + x
```

```asm
; @launch grid=(512,1,1) block=(320,1,1) lds=256
.amdgcn_target "amdgcn-amd-amdhsa--gfx950"
.text
.globl standalone__grn__sampling_kernel
.p2align 8
.type standalone__grn__sampling_kernel,@function
standalone__grn__sampling_kernel:
    s_load_dwordx8 s[4:11], s[0:1], 0
    s_setprio 3
    s_cmp_ge_u32 s2, 512
    s_cbranch_scc1 L_done
    v_lshrrev_b32 v6, 6, v0
    v_mov_b32 v5, 0
    v_and_b32 v1, 15, v0
    v_lshlrev_b32 v1, 4, v1
    v_lshl_add_u32 v1, v6, 8, v1
    v_bfe_u32 v7, v0, 4, 2
    s_mul_i32 s3, s2, 40960
    v_mul_u32_u24 v2, 0x1400, v7
    v_add3_u32 v2, v2, v1, s3
    v_lshl_add_u32 v3, v7, 2, v1
    v_mul_u32_u24 v5, 256, v5
    v_lshl_add_u32 v4, v7, 5, v5
    v_lshl_add_u32 v4, v6, 2, v4
    v_add_u32 v26, 20480, v2
    s_mov_b32 s12, 0xffff0000
    s_mov_b32 s13, 0x3acccccd
    s_mov_b32 s14, 0x358637bd
    s_waitcnt lgkmcnt(0)
    global_load_dwordx4 v[48:51], v2, s[4:5] offset:0 nt
    global_load_dwordx4 v[56:59], v2, s[4:5] offset:1280 nt
    global_load_dwordx4 v[64:67], v2, s[4:5] offset:2560 nt
    global_load_dwordx4 v[72:75], v2, s[4:5] offset:3840 nt
    global_load_dword v7, v3, s[6:7]
    global_load_dwordx4 v[12:15], v1, s[8:9]
    global_load_dwordx4 v[80:83], v26, s[4:5] offset:0 nt
    global_load_dwordx4 v[88:91], v26, s[4:5] offset:1280 nt
    global_load_dwordx4 v[96:99], v26, s[4:5] offset:2560 nt
    global_load_dwordx4 v[104:107], v26, s[4:5] offset:3840 nt
    s_setprio 1
    s_waitcnt vmcnt(9)
    v_lshlrev_b32 v44, 16, v48
    v_and_b32 v45, s12, v48
    v_lshlrev_b32 v46, 16, v49
    v_and_b32 v47, s12, v49
    v_lshlrev_b32 v48, 16, v50
    v_and_b32 v49, s12, v50
    v_lshlrev_b32 v50, 16, v51
    v_and_b32 v51, s12, v51
    v_pk_mul_f32 v[16:17], v[44:45], v[44:45]
    v_pk_mul_f32 v[18:19], v[46:47], v[46:47]
    v_pk_mul_f32 v[20:21], v[48:49], v[48:49]
    v_pk_mul_f32 v[22:23], v[50:51], v[50:51]
    s_waitcnt vmcnt(8)
    v_lshlrev_b32 v52, 16, v56
    v_and_b32 v53, s12, v56
    v_lshlrev_b32 v54, 16, v57
    v_and_b32 v55, s12, v57
    v_lshlrev_b32 v56, 16, v58
    v_and_b32 v57, s12, v58
    v_lshlrev_b32 v58, 16, v59
    v_and_b32 v59, s12, v59
    v_pk_fma_f32 v[16:17], v[52:53], v[52:53], v[16:17]
    v_pk_fma_f32 v[18:19], v[54:55], v[54:55], v[18:19]
    v_pk_fma_f32 v[20:21], v[56:57], v[56:57], v[20:21]
    v_pk_fma_f32 v[22:23], v[58:59], v[58:59], v[22:23]
    s_waitcnt vmcnt(7)
    v_lshlrev_b32 v60, 16, v64
    v_and_b32 v61, s12, v64
    v_lshlrev_b32 v62, 16, v65
    v_and_b32 v63, s12, v65
    v_lshlrev_b32 v64, 16, v66
    v_and_b32 v65, s12, v66
    v_lshlrev_b32 v66, 16, v67
    v_and_b32 v67, s12, v67
    v_pk_fma_f32 v[16:17], v[60:61], v[60:61], v[16:17]
    v_pk_fma_f32 v[18:19], v[62:63], v[62:63], v[18:19]
    v_pk_fma_f32 v[20:21], v[64:65], v[64:65], v[20:21]
    v_pk_fma_f32 v[22:23], v[66:67], v[66:67], v[22:23]
    s_waitcnt vmcnt(6)
    v_lshlrev_b32 v68, 16, v72
    v_and_b32 v69, s12, v72
    v_lshlrev_b32 v70, 16, v73
    v_and_b32 v71, s12, v73
    v_lshlrev_b32 v72, 16, v74
    v_and_b32 v73, s12, v74
    v_lshlrev_b32 v74, 16, v75
    v_and_b32 v75, s12, v75
    v_pk_fma_f32 v[16:17], v[68:69], v[68:69], v[16:17]
    v_pk_fma_f32 v[18:19], v[70:71], v[70:71], v[18:19]
    v_pk_fma_f32 v[20:21], v[72:73], v[72:73], v[20:21]
    v_pk_fma_f32 v[22:23], v[74:75], v[74:75], v[22:23]
    s_nop 1
    v_permlane32_swap_b32 v16, v20
    v_permlane32_swap_b32 v17, v21
    v_permlane32_swap_b32 v18, v22
    v_permlane32_swap_b32 v19, v23
    v_pk_add_f32 v[16:17], v[16:17], v[20:21]
    v_pk_add_f32 v[18:19], v[18:19], v[22:23]
    s_nop 1
    v_permlane16_swap_b32 v16, v18
    v_permlane16_swap_b32 v17, v19
    v_add_f32 v16, v16, v18
    v_add_f32 v17, v17, v19
    v_sqrt_f32 v16, v16
    v_sqrt_f32 v17, v17
    s_waitcnt vmcnt(5)
    v_lshlrev_b32 v24, 16, v7
    v_and_b32 v25, s12, v7
    v_add_f32 v18, v16, v17
    v_mul_f32 v28, v24, v16
    v_mul_f32 v29, v25, v17
    v_add_f32_dpp v18, v18, v18 quad_perm:[1,0,3,2] row_mask:0xf bank_mask:0xf
    v_mov_b32 v30, v28
    v_mov_b32 v31, v29
    v_add_f32_dpp v18, v18, v18 quad_perm:[2,3,0,1] row_mask:0xf bank_mask:0xf
    s_nop 0
    v_permlane16_swap_b32 v28, v30
    v_add_f32_dpp v18, v18, v18 row_half_mirror row_mask:0xf bank_mask:0xf
    v_permlane16_swap_b32 v29, v31
    v_mov_b32 v32, v28
    v_add_f32_dpp v18, v18, v18 row_mirror row_mask:0xf bank_mask:0xf
    v_mov_b32 v33, v29
    v_mov_b32 v34, v30
    v_add_f32_dpp v18, v18, v18 row_bcast:15 row_mask:0xa bank_mask:0xf
    v_mov_b32 v35, v31
    v_permlane32_swap_b32 v28, v32
    v_add_f32_dpp v18, v18, v18 row_bcast:31 row_mask:0xc bank_mask:0xf
    v_permlane32_swap_b32 v29, v33
    ds_write_b32 v4, v18 offset:0
    v_permlane32_swap_b32 v30, v34
    v_permlane32_swap_b32 v31, v35
    s_waitcnt vmcnt(4)
    v_lshlrev_b32 v8, 16, v12
    v_and_b32 v9, s12, v12
    v_lshlrev_b32 v10, 16, v13
    v_and_b32 v11, s12, v13
    v_lshlrev_b32 v12, 16, v14
    v_and_b32 v13, s12, v14
    v_lshlrev_b32 v14, 16, v15
    v_and_b32 v15, s12, v15
    s_waitcnt vmcnt(3)
    v_lshlrev_b32 v76, 16, v80
    v_and_b32 v77, s12, v80
    v_lshlrev_b32 v78, 16, v81
    v_and_b32 v79, s12, v81
    v_lshlrev_b32 v80, 16, v82
    v_and_b32 v81, s12, v82
    v_lshlrev_b32 v82, 16, v83
    v_and_b32 v83, s12, v83
    v_pk_mul_f32 v[16:17], v[76:77], v[76:77]
    v_pk_mul_f32 v[18:19], v[78:79], v[78:79]
    v_pk_mul_f32 v[20:21], v[80:81], v[80:81]
    v_pk_mul_f32 v[22:23], v[82:83], v[82:83]
    s_waitcnt vmcnt(2)
    v_lshlrev_b32 v84, 16, v88
    v_and_b32 v85, s12, v88
    v_lshlrev_b32 v86, 16, v89
    v_and_b32 v87, s12, v89
    v_lshlrev_b32 v88, 16, v90
    v_and_b32 v89, s12, v90
    v_lshlrev_b32 v90, 16, v91
    v_and_b32 v91, s12, v91
    v_pk_fma_f32 v[16:17], v[84:85], v[84:85], v[16:17]
    v_pk_fma_f32 v[18:19], v[86:87], v[86:87], v[18:19]
    v_pk_fma_f32 v[20:21], v[88:89], v[88:89], v[20:21]
    v_pk_fma_f32 v[22:23], v[90:91], v[90:91], v[22:23]
    s_waitcnt vmcnt(1)
    v_lshlrev_b32 v92, 16, v96
    v_and_b32 v93, s12, v96
    v_lshlrev_b32 v94, 16, v97
    v_and_b32 v95, s12, v97
    v_lshlrev_b32 v96, 16, v98
    v_and_b32 v97, s12, v98
    v_lshlrev_b32 v98, 16, v99
    v_and_b32 v99, s12, v99
    v_pk_fma_f32 v[16:17], v[92:93], v[92:93], v[16:17]
    v_pk_fma_f32 v[18:19], v[94:95], v[94:95], v[18:19]
    v_pk_fma_f32 v[20:21], v[96:97], v[96:97], v[20:21]
    v_pk_fma_f32 v[22:23], v[98:99], v[98:99], v[22:23]
    s_waitcnt vmcnt(0)
    v_lshlrev_b32 v100, 16, v104
    v_and_b32 v101, s12, v104
    v_lshlrev_b32 v102, 16, v105
    v_and_b32 v103, s12, v105
    v_lshlrev_b32 v104, 16, v106
    v_and_b32 v105, s12, v106
    v_lshlrev_b32 v106, 16, v107
    v_and_b32 v107, s12, v107
    v_pk_fma_f32 v[16:17], v[100:101], v[100:101], v[16:17]
    v_pk_fma_f32 v[18:19], v[102:103], v[102:103], v[18:19]
    v_pk_fma_f32 v[20:21], v[104:105], v[104:105], v[20:21]
    v_pk_fma_f32 v[22:23], v[106:107], v[106:107], v[22:23]
    s_nop 1
    v_permlane32_swap_b32 v16, v20
    v_permlane32_swap_b32 v17, v21
    v_permlane32_swap_b32 v18, v22
    v_permlane32_swap_b32 v19, v23
    v_pk_add_f32 v[16:17], v[16:17], v[20:21]
    v_pk_add_f32 v[18:19], v[18:19], v[22:23]
    s_nop 1
    v_permlane16_swap_b32 v16, v18
    v_permlane16_swap_b32 v17, v19
    v_add_f32 v16, v16, v18
    v_add_f32 v17, v17, v19
    v_sqrt_f32 v16, v16
    v_sqrt_f32 v17, v17
    s_nop 0
    v_add_f32 v18, v16, v17
    v_mul_f32 v36, v24, v16
    v_mul_f32 v37, v25, v17
    v_add_f32_dpp v18, v18, v18 quad_perm:[1,0,3,2] row_mask:0xf bank_mask:0xf
    v_mov_b32 v38, v36
    v_mov_b32 v39, v37
    v_add_f32_dpp v18, v18, v18 quad_perm:[2,3,0,1] row_mask:0xf bank_mask:0xf
    s_nop 0
    v_permlane16_swap_b32 v36, v38
    v_add_f32_dpp v18, v18, v18 row_half_mirror row_mask:0xf bank_mask:0xf
    v_permlane16_swap_b32 v37, v39
    v_mov_b32 v40, v36
    v_add_f32_dpp v18, v18, v18 row_mirror row_mask:0xf bank_mask:0xf
    v_mov_b32 v41, v37
    v_mov_b32 v42, v38
    v_add_f32_dpp v18, v18, v18 row_bcast:15 row_mask:0xa bank_mask:0xf
    v_mov_b32 v43, v39
    v_permlane32_swap_b32 v36, v40
    v_add_f32_dpp v18, v18, v18 row_bcast:31 row_mask:0xc bank_mask:0xf
    v_permlane32_swap_b32 v37, v41
    ds_write_b32 v4, v18 offset:128
    v_permlane32_swap_b32 v38, v42
    v_permlane32_swap_b32 v39, v43
    s_waitcnt lgkmcnt(0)
    s_barrier
    ds_read_b128 v[16:19], v5 offset:96
    ds_read_b32 v20, v5 offset:112
    v_mov_b32 v21, s14
    s_waitcnt lgkmcnt(0)
    v_add_f32 v16, v16, v17
    v_add_f32 v18, v18, v19
    v_add_f32 v16, v16, v20
    v_add_f32 v16, v16, v18
    v_fma_f32 v16, v16, s13, v21
    v_rcp_f32 v16, v16
    s_nop 0
    v_fma_f32 v28, v28, v16, 1.0
    v_fma_f32 v29, v29, v16, 1.0
    v_fma_f32 v30, v30, v16, 1.0
    v_fma_f32 v31, v31, v16, 1.0
    v_fma_f32 v32, v32, v16, 1.0
    v_fma_f32 v33, v33, v16, 1.0
    v_fma_f32 v34, v34, v16, 1.0
    v_fma_f32 v35, v35, v16, 1.0
    v_pk_fma_f32 v[44:45], v[44:45], v[28:29], v[8:9]
    v_pk_fma_f32 v[46:47], v[46:47], v[30:31], v[10:11]
    v_pk_fma_f32 v[48:49], v[48:49], v[32:33], v[12:13]
    v_pk_fma_f32 v[50:51], v[50:51], v[34:35], v[14:15]
    v_cvt_pk_bf16_f32 v44, v44, v45
    v_cvt_pk_bf16_f32 v45, v46, v47
    v_cvt_pk_bf16_f32 v46, v48, v49
    v_cvt_pk_bf16_f32 v47, v50, v51
    s_setprio 0
    global_store_dwordx4 v2, v[44:47], s[10:11] offset:0 nt
    v_pk_fma_f32 v[52:53], v[52:53], v[28:29], v[8:9]
    v_pk_fma_f32 v[54:55], v[54:55], v[30:31], v[10:11]
    v_pk_fma_f32 v[56:57], v[56:57], v[32:33], v[12:13]
    v_pk_fma_f32 v[58:59], v[58:59], v[34:35], v[14:15]
    v_cvt_pk_bf16_f32 v52, v52, v53
    v_cvt_pk_bf16_f32 v53, v54, v55
    v_cvt_pk_bf16_f32 v54, v56, v57
    v_cvt_pk_bf16_f32 v55, v58, v59
    global_store_dwordx4 v2, v[52:55], s[10:11] offset:1280 nt
    v_pk_fma_f32 v[60:61], v[60:61], v[28:29], v[8:9]
    v_pk_fma_f32 v[62:63], v[62:63], v[30:31], v[10:11]
    v_pk_fma_f32 v[64:65], v[64:65], v[32:33], v[12:13]
    v_pk_fma_f32 v[66:67], v[66:67], v[34:35], v[14:15]
    v_cvt_pk_bf16_f32 v60, v60, v61
    v_cvt_pk_bf16_f32 v61, v62, v63
    v_cvt_pk_bf16_f32 v62, v64, v65
    v_cvt_pk_bf16_f32 v63, v66, v67
    global_store_dwordx4 v2, v[60:63], s[10:11] offset:2560 nt
    v_pk_fma_f32 v[68:69], v[68:69], v[28:29], v[8:9]
    v_pk_fma_f32 v[70:71], v[70:71], v[30:31], v[10:11]
    v_pk_fma_f32 v[72:73], v[72:73], v[32:33], v[12:13]
    v_pk_fma_f32 v[74:75], v[74:75], v[34:35], v[14:15]
    v_cvt_pk_bf16_f32 v68, v68, v69
    v_cvt_pk_bf16_f32 v69, v70, v71
    v_cvt_pk_bf16_f32 v70, v72, v73
    v_cvt_pk_bf16_f32 v71, v74, v75
    global_store_dwordx4 v2, v[68:71], s[10:11] offset:3840 nt
    ds_read_b128 v[16:19], v5 offset:224
    ds_read_b32 v20, v5 offset:240
    v_mov_b32 v21, s14
    s_waitcnt lgkmcnt(0)
    v_add_f32 v16, v16, v17
    v_add_f32 v18, v18, v19
    v_add_f32 v16, v16, v20
    v_add_f32 v16, v16, v18
    v_fma_f32 v16, v16, s13, v21
    v_rcp_f32 v16, v16
    s_nop 0
    v_fma_f32 v36, v36, v16, 1.0
    v_fma_f32 v37, v37, v16, 1.0
    v_fma_f32 v38, v38, v16, 1.0
    v_fma_f32 v39, v39, v16, 1.0
    v_fma_f32 v40, v40, v16, 1.0
    v_fma_f32 v41, v41, v16, 1.0
    v_fma_f32 v42, v42, v16, 1.0
    v_fma_f32 v43, v43, v16, 1.0
    v_pk_fma_f32 v[76:77], v[76:77], v[36:37], v[8:9]
    v_pk_fma_f32 v[78:79], v[78:79], v[38:39], v[10:11]
    v_pk_fma_f32 v[80:81], v[80:81], v[40:41], v[12:13]
    v_pk_fma_f32 v[82:83], v[82:83], v[42:43], v[14:15]
    v_cvt_pk_bf16_f32 v76, v76, v77
    v_cvt_pk_bf16_f32 v77, v78, v79
    v_cvt_pk_bf16_f32 v78, v80, v81
    v_cvt_pk_bf16_f32 v79, v82, v83
    global_store_dwordx4 v26, v[76:79], s[10:11] offset:0 nt
    v_pk_fma_f32 v[84:85], v[84:85], v[36:37], v[8:9]
    v_pk_fma_f32 v[86:87], v[86:87], v[38:39], v[10:11]
    v_pk_fma_f32 v[88:89], v[88:89], v[40:41], v[12:13]
    v_pk_fma_f32 v[90:91], v[90:91], v[42:43], v[14:15]
    v_cvt_pk_bf16_f32 v84, v84, v85
    v_cvt_pk_bf16_f32 v85, v86, v87
    v_cvt_pk_bf16_f32 v86, v88, v89
    v_cvt_pk_bf16_f32 v87, v90, v91
    global_store_dwordx4 v26, v[84:87], s[10:11] offset:1280 nt
    v_pk_fma_f32 v[92:93], v[92:93], v[36:37], v[8:9]
    v_pk_fma_f32 v[94:95], v[94:95], v[38:39], v[10:11]
    v_pk_fma_f32 v[96:97], v[96:97], v[40:41], v[12:13]
    v_pk_fma_f32 v[98:99], v[98:99], v[42:43], v[14:15]
    v_cvt_pk_bf16_f32 v92, v92, v93
    v_cvt_pk_bf16_f32 v93, v94, v95
    v_cvt_pk_bf16_f32 v94, v96, v97
    v_cvt_pk_bf16_f32 v95, v98, v99
    global_store_dwordx4 v26, v[92:95], s[10:11] offset:2560 nt
    v_pk_fma_f32 v[100:101], v[100:101], v[36:37], v[8:9]
    v_pk_fma_f32 v[102:103], v[102:103], v[38:39], v[10:11]
    v_pk_fma_f32 v[104:105], v[104:105], v[40:41], v[12:13]
    v_pk_fma_f32 v[106:107], v[106:107], v[42:43], v[14:15]
    v_cvt_pk_bf16_f32 v100, v100, v101
    v_cvt_pk_bf16_f32 v101, v102, v103
    v_cvt_pk_bf16_f32 v102, v104, v105
    v_cvt_pk_bf16_f32 v103, v106, v107
    global_store_dwordx4 v26, v[100:103], s[10:11] offset:3840 nt
L_done:
    s_endpgm
.section .rodata,"a"
.p2align 6
.amdhsa_kernel standalone__grn__sampling_kernel
  .amdhsa_next_free_vgpr 108
  .amdhsa_next_free_sgpr 24
  .amdhsa_accum_offset 108
  .amdhsa_group_segment_fixed_size 0
  .amdhsa_kernarg_size 48
  .amdhsa_user_sgpr_count 2
  .amdhsa_user_sgpr_kernarg_segment_ptr 1
  .amdhsa_system_sgpr_workgroup_id_x 1
  .amdhsa_float_denorm_mode_32 3
  .amdhsa_float_denorm_mode_16_64 3
.end_amdhsa_kernel
```
